```python
import torch

def _softmax(x, axis=-1):
    return torch.softmax(x, dim=axis)
def _gelu(x):
    return torch.nn.functional.gelu(x, approximate="tanh")
def _silu(x):
    return torch.nn.functional.silu(x)
def _sigmoid(x):
    return torch.sigmoid(x)
def _layernorm(x, axis=-1, eps=1e-5):
    m = x.mean(dim=axis, keepdim=True)
    v = x.var(dim=axis, keepdim=True, unbiased=False)
    return (x - m) / torch.sqrt(v + eps)
def _scatter_add(tgt, idx, src, axis=0):
    return tgt.clone().index_add_(axis, idx, src)
def _segment_sum(src, seg, n):
    out = torch.zeros((n,) + src.shape[1:], dtype=src.dtype)
    return out.index_add_(0, seg, src)
def _pad(x, pw):
    flat = tuple(v for pair in reversed(pw) for v in pair)
    return torch.nn.functional.pad(x, flat)

kernel_name = 'standalone__kv_cache_quant_int4_int2_kv_with_per_channel_or_per_token_scales__decode'

def setup_inputs():

    _w = (lambda a: (lambda t: t.to(torch.bfloat16) if t.is_floating_point() else t)(torch.as_tensor(a)))
    B = 4
    Sq = 1
    Skv = 4096
    Hq = 32
    Hkv = 8
    Dh = 128
    bits = 8
    G = -1
    if G <= 0 or G >= Skv:
        G = max(1, Skv // 2)
    Skv = (Skv // G) * G
    ngk = Skv // G
    qmax = (1 << bits) - 1
    return {
        "q": _w((lambda *s: torch.randn(*s, dtype=torch.bfloat16) * 0.2)(B, Hq, Sq, Dh)),
        "qk": _w(torch.randint(0, qmax + 1, (B, Hkv, Skv, Dh)).to(torch.int32)),
        "qv": _w(torch.randint(0, qmax + 1, (B, Hkv, Skv, Dh)).to(torch.int32)),
        "k_scales": _w(torch.abs((lambda *s: torch.randn(*s, dtype=torch.bfloat16) * 0.2)(B, Hkv, ngk, Dh)) * 0.05 + 0.02),
        "k_zeros": _w((lambda *s: torch.randn(*s, dtype=torch.bfloat16) * 0.2)(B, Hkv, ngk, Dh) + float(qmax) / 2.0),
        "v_scales": _w(torch.abs((lambda *s: torch.randn(*s, dtype=torch.bfloat16) * 0.05)(B, Hkv, Skv, 1)) * 0.05 + 0.02),
        "v_zeros": _w((lambda *s: torch.randn(*s, dtype=torch.bfloat16) * 0.05)(B, Hkv, Skv, 1) + float(qmax) / 2.0),
    }

def reference(q, qk, qv, k_scales, k_zeros, v_scales, v_zeros):
    B, Hq, Sq, Dh = q.shape
    Hkv, Skv = qk.shape[1], qk.shape[2]
    ngk = k_scales.shape[2]
    G = Skv // ngk
    ks = (lambda x, n, axis: torch.repeat_interleave(x, n, dim=axis))(k_scales, G, axis=2)
    kz = (lambda x, n, axis: torch.repeat_interleave(x, n, dim=axis))(k_zeros, G, axis=2)
    k = ((lambda x, dt: x.to(dt))(qk, q.dtype) - kz) * ks
    v = ((lambda x, dt: x.to(dt))(qv, q.dtype) - v_zeros) * v_scales
    rep = Hq // Hkv
    if rep > 1:
        k = (lambda x, n, axis: torch.repeat_interleave(x, n, dim=axis))(k, rep, axis=1)
        v = (lambda x, n, axis: torch.repeat_interleave(x, n, dim=axis))(v, rep, axis=1)
    scale = float(Dh) ** -0.5
    logits = torch.einsum("bhqd,bhkd->bhqk", q, k) * scale
    p = _softmax(logits, axis=-1)
    o = torch.einsum("bhqk,bhkd->bhqd", p, v)
    return o
```

```asm
; @launch grid=(256,1,1) block=(512,1,1) lds=16784
.amdgcn_target "amdgcn-amd-amdhsa--gfx950"
.text
.globl standalone__kv_cache_quant_int4_int2_kv_with_per_channel_or_per_token_scales__decode_kernel
.p2align 8
.type standalone__kv_cache_quant_int4_int2_kv_with_per_channel_or_per_token_scales__decode_kernel,@function
standalone__kv_cache_quant_int4_int2_kv_with_per_channel_or_per_token_scales__decode_kernel:
    s_cmp_ge_u32 s2, 256
    s_cbranch_scc1 L_end
    s_load_dwordx16 s[4:19], s[0:1], 0
    s_load_dwordx4 s[20:23], s[0:1], 64
    v_lshrrev_b32 v6, 6, v0
    v_and_b32 v5, 63, v0
    v_readfirstlane_b32 s80, v6
    v_and_b32 v8, 15, v0
    v_bfe_u32 v7, v0, 4, 2
    v_and_b32 v12, 7, v0
    v_bfe_u32 v13, v0, 3, 1
    v_lshlrev_b32 v1, 9, v12
    v_lshl_add_u32 v1, v13, 6, v1
    v_lshl_add_u32 v1, v7, 4, v1
    v_add_u32 v2, 0x1000, v1
    s_and_b32 s76, s2, 31
    s_lshr_b32 s77, s2, 5
    s_lshl_b32 s78, s76, 3
    s_add_u32 s78, s78, s77
    s_lshl_b32 s79, s78, 18
    s_lshl_b32 s96, s80, 13
    s_add_u32 s97, s96, 0x10000
    s_add_u32 s98, s96, 0x20000
    s_add_u32 s99, s96, 0x30000
    v_lshlrev_b32 v14, 4, v5
    v_lshlrev_b32 v15, 4, v8
    v_lshlrev_b32 v4, 3, v7
    s_mov_b32 s26, 0x40000
    s_mov_b32 s27, 0x20000
    s_mov_b32 s34, 0x400
    s_mov_b32 s35, 0x20000
    s_mov_b32 s38, 0x100
    s_mov_b32 s39, 0x20000
    s_mov_b32 s42, 0x100
    s_mov_b32 s43, 0x20000
    s_lshl_b32 s84, s76, 10
    s_lshr_b32 s81, s77, 2
    s_lshl_b32 s82, s76, 1
    s_add_u32 s81, s81, s82
    s_lshl_b32 s85, s81, 8
    s_waitcnt lgkmcnt(0)
    s_add_u32 s24, s6, s79
    s_addc_u32 s25, s7, 0
    s_and_b32 s25, s25, 0xffff
    buffer_load_dwordx4 v[128:131], v1, s[24:27], s96 offen offset:0 nt
    buffer_load_dwordx4 v[132:135], v1, s[24:27], s96 offen offset:128 nt
    buffer_load_dwordx4 v[136:139], v1, s[24:27], s96 offen offset:256 nt
    buffer_load_dwordx4 v[140:143], v1, s[24:27], s96 offen offset:384 nt
    buffer_load_dwordx4 v[144:147], v2, s[24:27], s96 offen offset:0 nt
    buffer_load_dwordx4 v[148:151], v2, s[24:27], s96 offen offset:128 nt
    buffer_load_dwordx4 v[152:155], v2, s[24:27], s96 offen offset:256 nt
    buffer_load_dwordx4 v[156:159], v2, s[24:27], s96 offen offset:384 nt
    s_add_u32 s32, s4, s84
    s_addc_u32 s33, s5, 0
    s_and_b32 s33, s33, 0xffff
    s_add_u32 s36, s10, s85
    s_addc_u32 s37, s11, 0
    s_and_b32 s37, s37, 0xffff
    s_add_u32 s40, s12, s85
    s_addc_u32 s41, s13, 0
    s_and_b32 s41, s41, 0xffff
    buffer_load_dwordx4 v[44:47], v14, s[32:35], 0 offen
    buffer_load_dwordx4 v[48:51], v15, s[36:39], 0 offen
    buffer_load_dwordx4 v[52:55], v15, s[40:43], 0 offen
    s_lshl_b32 s94, s77, 11
    s_lshl_b32 s100, s77, 7
    s_lshl_b32 s81, s76, 14
    s_add_u32 s52, s22, s81
    s_addc_u32 s53, s23, 0
    s_and_b32 s53, s53, 0xffff
    s_mov_b32 s54, 0x4000
    s_mov_b32 s55, 0x20000
    s_lshl_b32 s81, s76, 10
    s_add_u32 s81, s81, 0x100000
    s_add_u32 s4, s22, s81
    s_addc_u32 s5, s23, 0
    s_and_b32 s5, s5, 0xffff
    s_mov_b32 s6, 0x400
    s_mov_b32 s7, 0x20000
    s_lshl_b32 s81, s76, 7
    s_add_u32 s81, s81, 0x110000
    s_add_u32 s60, s22, s81
    s_addc_u32 s61, s23, 0
    s_and_b32 s61, s61, 0xffff
    s_mov_b32 s62, 0x80
    s_mov_b32 s63, 0x20000
    s_add_u32 s28, s8, s79
    s_addc_u32 s29, s9, 0
    s_and_b32 s29, s29, 0xffff
    s_mov_b32 s30, 0x40000
    s_mov_b32 s31, 0x20000
    v_lshlrev_b32 v3, 11, v7
    v_lshl_add_u32 v3, v8, 4, v3
    v_lshl_add_u32 v10, v6, 11, v14
    s_lshl_b32 s95, s76, 2
    s_lshl_b32 s81, s76, 10
    s_add_u32 s56, s18, s81
    s_addc_u32 s57, s19, 0
    s_and_b32 s57, s57, 0xffff
    s_mov_b32 s58, 0x400
    s_mov_b32 s59, 0x20000
    s_mov_b32 s67, 0x3e0293ee
    s_mov_b32 s68, 0x000f000f
    s_mov_b32 s69, 0x000f000f
    s_mov_b32 s70, 0x00f000f0
    s_mov_b32 s71, 0x00f000f0
    s_mov_b32 s72, 0x0f000f00
    s_mov_b32 s73, 0x0f000f00
    s_mov_b32 s74, 0xf000f000
    s_mov_b32 s75, 0xf000f000
    s_waitcnt vmcnt(0)
    v_lshlrev_b32 v28, 16, v44
    v_and_b32 v29, 0xffff0000, v44
    v_lshlrev_b32 v30, 16, v48
    v_and_b32 v31, 0xffff0000, v48
    v_mul_f32 v28, v28, v30
    v_mul_f32 v29, v29, v31
    v_cvt_pk_bf16_f32 v44, v28, v29
    v_xor_b32 v52, 0x80008000, v52
    v_lshlrev_b32 v28, 16, v45
    v_and_b32 v29, 0xffff0000, v45
    v_lshlrev_b32 v30, 16, v49
    v_and_b32 v31, 0xffff0000, v49
    v_mul_f32 v28, v28, v30
    v_mul_f32 v29, v29, v31
    v_cvt_pk_bf16_f32 v45, v28, v29
    v_xor_b32 v53, 0x80008000, v53
    v_lshlrev_b32 v28, 16, v46
    v_and_b32 v29, 0xffff0000, v46
    v_lshlrev_b32 v30, 16, v50
    v_and_b32 v31, 0xffff0000, v50
    v_mul_f32 v28, v28, v30
    v_mul_f32 v29, v29, v31
    v_cvt_pk_bf16_f32 v46, v28, v29
    v_xor_b32 v54, 0x80008000, v54
    v_lshlrev_b32 v28, 16, v47
    v_and_b32 v29, 0xffff0000, v47
    v_lshlrev_b32 v30, 16, v51
    v_and_b32 v31, 0xffff0000, v51
    v_mul_f32 v28, v28, v30
    v_mul_f32 v29, v29, v31
    v_cvt_pk_bf16_f32 v47, v28, v29
    v_xor_b32 v55, 0x80008000, v55
    ds_write_b128 v10, v[44:47]
    v_lshl_add_u32 v12, v6, 11, v15
    ds_write_b128 v12, v[52:55] offset:1024
    v_and_b32 v28, 3, v0
    v_bfe_u32 v29, v0, 2, 1
    v_bfe_u32 v30, v0, 3, 1
    v_lshlrev_b32 v31, 11, v6
    v_lshl_add_u32 v31, v7, 3, v31
    v_lshl_add_u32 v12, v28, 8, v31
    v_lshl_add_u32 v12, v29, 5, v12
    v_lshl_add_u32 v13, v30, 5, v31
    v_lshlrev_b32 v8, 5, v28
    v_lshl_add_u32 v9, v6, 2, v8
    ds_read2_b64 v[16:19], v12 offset0:0 offset1:8
    ds_read2_b64 v[20:23], v12 offset0:16 offset1:24
    ds_read2_b64 v[32:35], v13 offset0:128 offset1:136
    ds_read2_b64 v[36:39], v13 offset0:144 offset1:152
    s_waitcnt lgkmcnt(0)
    v_mfma_f32_16x16x32_bf16 v[24:27], v[32:35], v[16:19], 0
    v_mfma_f32_16x16x32_bf16 v[24:27], v[36:39], v[20:23], v[24:27]
    s_waitcnt vmcnt(3)
    v_cvt_f32_i32 v128, v128
    v_cvt_f32_i32 v129, v129
    v_cvt_f32_i32 v130, v130
    v_cvt_f32_i32 v131, v131
    v_cvt_f32_i32 v132, v132
    v_cvt_f32_i32 v133, v133
    v_cvt_f32_i32 v134, v134
    v_cvt_f32_i32 v135, v135
    v_cvt_pk_bf16_f32 v128, v128, v129
    v_cvt_pk_bf16_f32 v129, v130, v131
    v_cvt_pk_bf16_f32 v130, v132, v133
    v_cvt_pk_bf16_f32 v131, v134, v135
    v_cvt_f32_i32 v136, v136
    v_cvt_f32_i32 v137, v137
    v_cvt_f32_i32 v138, v138
    v_cvt_f32_i32 v139, v139
    v_cvt_f32_i32 v140, v140
    v_cvt_f32_i32 v141, v141
    v_cvt_f32_i32 v142, v142
    v_cvt_f32_i32 v143, v143
    v_mfma_f32_16x16x32_bf16 v[28:31], v[128:131], v[16:19], v[24:27]
    v_cvt_pk_bf16_f32 v136, v136, v137
    v_cvt_pk_bf16_f32 v137, v138, v139
    v_cvt_pk_bf16_f32 v138, v140, v141
    v_cvt_pk_bf16_f32 v139, v142, v143
    v_cvt_f32_i32 v144, v144
    v_cvt_f32_i32 v145, v145
    v_cvt_f32_i32 v146, v146
    v_cvt_f32_i32 v147, v147
    v_cvt_f32_i32 v148, v148
    v_cvt_f32_i32 v149, v149
    v_cvt_f32_i32 v150, v150
    v_cvt_f32_i32 v151, v151
    v_mfma_f32_16x16x32_bf16 v[28:31], v[136:139], v[20:23], v[28:31]
    v_cvt_pk_bf16_f32 v144, v144, v145
    v_cvt_pk_bf16_f32 v145, v146, v147
    v_cvt_pk_bf16_f32 v146, v148, v149
    v_cvt_pk_bf16_f32 v147, v150, v151
    v_cvt_f32_i32 v152, v152
    v_cvt_f32_i32 v153, v153
    v_cvt_f32_i32 v154, v154
    v_cvt_f32_i32 v155, v155
    v_cvt_f32_i32 v156, v156
    v_cvt_f32_i32 v157, v157
    v_cvt_f32_i32 v158, v158
    v_cvt_f32_i32 v159, v159
    v_mfma_f32_16x16x32_bf16 v[44:47], v[144:147], v[16:19], v[24:27]
    v_cvt_pk_bf16_f32 v152, v152, v153
    v_cvt_pk_bf16_f32 v153, v154, v155
    v_cvt_pk_bf16_f32 v154, v156, v157
    v_cvt_pk_bf16_f32 v155, v158, v159
    s_nop 1
    v_mfma_f32_16x16x32_bf16 v[44:47], v[152:155], v[20:23], v[44:47]
    buffer_load_dwordx4 v[128:131], v1, s[24:27], s97 offen offset:0 nt
    buffer_load_dwordx4 v[132:135], v1, s[24:27], s97 offen offset:128 nt
    buffer_load_dwordx4 v[136:139], v1, s[24:27], s97 offen offset:256 nt
    buffer_load_dwordx4 v[140:143], v1, s[24:27], s97 offen offset:384 nt
    buffer_load_dwordx4 v[144:147], v2, s[24:27], s97 offen offset:0 nt
    buffer_load_dwordx4 v[148:151], v2, s[24:27], s97 offen offset:128 nt
    buffer_load_dwordx4 v[152:155], v2, s[24:27], s97 offen offset:256 nt
    buffer_load_dwordx4 v[156:159], v2, s[24:27], s97 offen offset:384 nt
    s_waitcnt vmcnt(0)
    v_cvt_f32_i32 v128, v128
    v_cvt_f32_i32 v129, v129
    v_cvt_f32_i32 v130, v130
    v_cvt_f32_i32 v131, v131
    v_cvt_f32_i32 v132, v132
    v_cvt_f32_i32 v133, v133
    v_cvt_f32_i32 v134, v134
    v_cvt_f32_i32 v135, v135
    v_cvt_pk_bf16_f32 v128, v128, v129
    v_cvt_pk_bf16_f32 v129, v130, v131
    v_cvt_pk_bf16_f32 v130, v132, v133
    v_cvt_pk_bf16_f32 v131, v134, v135
    v_cvt_f32_i32 v136, v136
    v_cvt_f32_i32 v137, v137
    v_cvt_f32_i32 v138, v138
    v_cvt_f32_i32 v139, v139
    v_cvt_f32_i32 v140, v140
    v_cvt_f32_i32 v141, v141
    v_cvt_f32_i32 v142, v142
    v_cvt_f32_i32 v143, v143
    v_mfma_f32_16x16x32_bf16 v[32:35], v[128:131], v[16:19], v[24:27]
    v_cvt_pk_bf16_f32 v136, v136, v137
    v_cvt_pk_bf16_f32 v137, v138, v139
    v_cvt_pk_bf16_f32 v138, v140, v141
    v_cvt_pk_bf16_f32 v139, v142, v143
    v_cvt_f32_i32 v144, v144
    v_cvt_f32_i32 v145, v145
    v_cvt_f32_i32 v146, v146
    v_cvt_f32_i32 v147, v147
    v_cvt_f32_i32 v148, v148
    v_cvt_f32_i32 v149, v149
    v_cvt_f32_i32 v150, v150
    v_cvt_f32_i32 v151, v151
    v_mfma_f32_16x16x32_bf16 v[32:35], v[136:139], v[20:23], v[32:35]
    v_cvt_pk_bf16_f32 v144, v144, v145
    v_cvt_pk_bf16_f32 v145, v146, v147
    v_cvt_pk_bf16_f32 v146, v148, v149
    v_cvt_pk_bf16_f32 v147, v150, v151
    v_cvt_f32_i32 v152, v152
    v_cvt_f32_i32 v153, v153
    v_cvt_f32_i32 v154, v154
    v_cvt_f32_i32 v155, v155
    v_cvt_f32_i32 v156, v156
    v_cvt_f32_i32 v157, v157
    v_cvt_f32_i32 v158, v158
    v_cvt_f32_i32 v159, v159
    v_mfma_f32_16x16x32_bf16 v[48:51], v[144:147], v[16:19], v[24:27]
    v_cvt_pk_bf16_f32 v152, v152, v153
    v_cvt_pk_bf16_f32 v153, v154, v155
    v_cvt_pk_bf16_f32 v154, v156, v157
    v_cvt_pk_bf16_f32 v155, v158, v159
    s_nop 1
    v_mfma_f32_16x16x32_bf16 v[48:51], v[152:155], v[20:23], v[48:51]
    s_cmp_lg_u32 s80, 1
    s_cbranch_scc1 L_nohdr
    v_mov_b32 v116, 0
    buffer_load_dword v115, v116, s[60:63], 0 offen
    s_cmp_lg_u32 s77, 7
    s_cbranch_scc1 L_nohdr
    buffer_load_dword v117, v116, s[56:59], 0 offen
L_nohdr:
    buffer_load_dwordx4 v[128:131], v1, s[24:27], s98 offen offset:0 nt
    buffer_load_dwordx4 v[132:135], v1, s[24:27], s98 offen offset:128 nt
    buffer_load_dwordx4 v[136:139], v1, s[24:27], s98 offen offset:256 nt
    buffer_load_dwordx4 v[140:143], v1, s[24:27], s98 offen offset:384 nt
    buffer_load_dwordx4 v[144:147], v2, s[24:27], s98 offen offset:0 nt
    buffer_load_dwordx4 v[148:151], v2, s[24:27], s98 offen offset:128 nt
    buffer_load_dwordx4 v[152:155], v2, s[24:27], s98 offen offset:256 nt
    buffer_load_dwordx4 v[156:159], v2, s[24:27], s98 offen offset:384 nt
    s_lshl_b32 s81, s78, 10
    s_add_u32 s44, s14, s81
    s_addc_u32 s45, s15, 0
    s_and_b32 s45, s45, 0xffff
    s_mov_b32 s46, 0x400
    s_mov_b32 s47, 0x20000
    s_add_u32 s48, s16, s81
    s_addc_u32 s49, s17, 0
    s_and_b32 s49, s49, 0xffff
    s_mov_b32 s50, 0x400
    s_mov_b32 s51, 0x20000
    s_lshr_b32 s81, s96, 8
    buffer_load_dwordx2 v[60:61], v4, s[44:47], s81 offen
    buffer_load_dwordx2 v[68:69], v4, s[48:51], s81 offen
    s_lshr_b32 s81, s97, 8
    buffer_load_dwordx2 v[62:63], v4, s[44:47], s81 offen
    buffer_load_dwordx2 v[70:71], v4, s[48:51], s81 offen
    s_lshr_b32 s81, s98, 8
    buffer_load_dwordx2 v[64:65], v4, s[44:47], s81 offen
    buffer_load_dwordx2 v[72:73], v4, s[48:51], s81 offen
    s_lshr_b32 s81, s99, 8
    buffer_load_dwordx2 v[66:67], v4, s[44:47], s81 offen
    buffer_load_dwordx2 v[74:75], v4, s[48:51], s81 offen
    s_waitcnt vmcnt(8)
    v_cvt_f32_i32 v128, v128
    v_cvt_f32_i32 v129, v129
    v_cvt_f32_i32 v130, v130
    v_cvt_f32_i32 v131, v131
    v_cvt_f32_i32 v132, v132
    v_cvt_f32_i32 v133, v133
    v_cvt_f32_i32 v134, v134
    v_cvt_f32_i32 v135, v135
    v_cvt_pk_bf16_f32 v128, v128, v129
    v_cvt_pk_bf16_f32 v129, v130, v131
    v_cvt_pk_bf16_f32 v130, v132, v133
    v_cvt_pk_bf16_f32 v131, v134, v135
    v_cvt_f32_i32 v136, v136
    v_cvt_f32_i32 v137, v137
    v_cvt_f32_i32 v138, v138
    v_cvt_f32_i32 v139, v139
    v_cvt_f32_i32 v140, v140
    v_cvt_f32_i32 v141, v141
    v_cvt_f32_i32 v142, v142
    v_cvt_f32_i32 v143, v143
    v_mfma_f32_16x16x32_bf16 v[36:39], v[128:131], v[16:19], v[24:27]
    v_cvt_pk_bf16_f32 v136, v136, v137
    v_cvt_pk_bf16_f32 v137, v138, v139
    v_cvt_pk_bf16_f32 v138, v140, v141
    v_cvt_pk_bf16_f32 v139, v142, v143
    v_cvt_f32_i32 v144, v144
    v_cvt_f32_i32 v145, v145
    v_cvt_f32_i32 v146, v146
    v_cvt_f32_i32 v147, v147
    v_cvt_f32_i32 v148, v148
    v_cvt_f32_i32 v149, v149
    v_cvt_f32_i32 v150, v150
    v_cvt_f32_i32 v151, v151
    v_mfma_f32_16x16x32_bf16 v[36:39], v[136:139], v[20:23], v[36:39]
    v_cvt_pk_bf16_f32 v144, v144, v145
    v_cvt_pk_bf16_f32 v145, v146, v147
    v_cvt_pk_bf16_f32 v146, v148, v149
    v_cvt_pk_bf16_f32 v147, v150, v151
    v_cvt_f32_i32 v152, v152
    v_cvt_f32_i32 v153, v153
    v_cvt_f32_i32 v154, v154
    v_cvt_f32_i32 v155, v155
    v_cvt_f32_i32 v156, v156
    v_cvt_f32_i32 v157, v157
    v_cvt_f32_i32 v158, v158
    v_cvt_f32_i32 v159, v159
    v_mfma_f32_16x16x32_bf16 v[52:55], v[144:147], v[16:19], v[24:27]
    v_cvt_pk_bf16_f32 v152, v152, v153
    v_cvt_pk_bf16_f32 v153, v154, v155
    v_cvt_pk_bf16_f32 v154, v156, v157
    v_cvt_pk_bf16_f32 v155, v158, v159
    s_nop 1
    v_mfma_f32_16x16x32_bf16 v[52:55], v[152:155], v[20:23], v[52:55]
    buffer_load_dwordx4 v[128:131], v1, s[24:27], s99 offen offset:0 nt
    buffer_load_dwordx4 v[132:135], v1, s[24:27], s99 offen offset:128 nt
    buffer_load_dwordx4 v[136:139], v1, s[24:27], s99 offen offset:256 nt
    buffer_load_dwordx4 v[140:143], v1, s[24:27], s99 offen offset:384 nt
    buffer_load_dwordx4 v[144:147], v2, s[24:27], s99 offen offset:0 nt
    buffer_load_dwordx4 v[148:151], v2, s[24:27], s99 offen offset:128 nt
    buffer_load_dwordx4 v[152:155], v2, s[24:27], s99 offen offset:256 nt
    buffer_load_dwordx4 v[156:159], v2, s[24:27], s99 offen offset:384 nt
    s_waitcnt vmcnt(0)
    v_cvt_f32_i32 v128, v128
    v_cvt_f32_i32 v129, v129
    v_cvt_f32_i32 v130, v130
    v_cvt_f32_i32 v131, v131
    v_cvt_f32_i32 v132, v132
    v_cvt_f32_i32 v133, v133
    v_cvt_f32_i32 v134, v134
    v_cvt_f32_i32 v135, v135
    v_cvt_pk_bf16_f32 v128, v128, v129
    v_cvt_pk_bf16_f32 v129, v130, v131
    v_cvt_pk_bf16_f32 v130, v132, v133
    v_cvt_pk_bf16_f32 v131, v134, v135
    v_cvt_f32_i32 v136, v136
    v_cvt_f32_i32 v137, v137
    v_cvt_f32_i32 v138, v138
    v_cvt_f32_i32 v139, v139
    v_cvt_f32_i32 v140, v140
    v_cvt_f32_i32 v141, v141
    v_cvt_f32_i32 v142, v142
    v_cvt_f32_i32 v143, v143
    v_mfma_f32_16x16x32_bf16 v[40:43], v[128:131], v[16:19], v[24:27]
    v_cvt_pk_bf16_f32 v136, v136, v137
    v_cvt_pk_bf16_f32 v137, v138, v139
    v_cvt_pk_bf16_f32 v138, v140, v141
    v_cvt_pk_bf16_f32 v139, v142, v143
    v_cvt_f32_i32 v144, v144
    v_cvt_f32_i32 v145, v145
    v_cvt_f32_i32 v146, v146
    v_cvt_f32_i32 v147, v147
    v_cvt_f32_i32 v148, v148
    v_cvt_f32_i32 v149, v149
    v_cvt_f32_i32 v150, v150
    v_cvt_f32_i32 v151, v151
    v_mfma_f32_16x16x32_bf16 v[40:43], v[136:139], v[20:23], v[40:43]
    v_cvt_pk_bf16_f32 v144, v144, v145
    v_cvt_pk_bf16_f32 v145, v146, v147
    v_cvt_pk_bf16_f32 v146, v148, v149
    v_cvt_pk_bf16_f32 v147, v150, v151
    v_cvt_f32_i32 v152, v152
    v_cvt_f32_i32 v153, v153
    v_cvt_f32_i32 v154, v154
    v_cvt_f32_i32 v155, v155
    v_cvt_f32_i32 v156, v156
    v_cvt_f32_i32 v157, v157
    v_cvt_f32_i32 v158, v158
    v_cvt_f32_i32 v159, v159
    v_mfma_f32_16x16x32_bf16 v[56:59], v[144:147], v[16:19], v[24:27]
    v_cvt_pk_bf16_f32 v152, v152, v153
    v_cvt_pk_bf16_f32 v153, v154, v155
    v_cvt_pk_bf16_f32 v154, v156, v157
    v_cvt_pk_bf16_f32 v155, v158, v159
    s_nop 1
    v_mfma_f32_16x16x32_bf16 v[56:59], v[152:155], v[20:23], v[56:59]
    buffer_load_dwordx4 v[128:131], v3, s[28:31], s96 offen offset:0 nt
    buffer_load_dwordx4 v[132:135], v3, s[28:31], s96 offen offset:512 nt
    buffer_load_dwordx4 v[136:139], v3, s[28:31], s96 offen offset:1024 nt
    buffer_load_dwordx4 v[140:143], v3, s[28:31], s96 offen offset:1536 nt
    buffer_load_dwordx4 v[144:147], v3, s[28:31], s96 offen offset:256 nt
    buffer_load_dwordx4 v[148:151], v3, s[28:31], s96 offen offset:768 nt
    buffer_load_dwordx4 v[152:155], v3, s[28:31], s96 offen offset:1280 nt
    buffer_load_dwordx4 v[156:159], v3, s[28:31], s96 offen offset:1792 nt
    s_waitcnt vmcnt(16)
    s_mov_b32 s66, 0xffffff00
    s_cmp_lg_u32 s80, 1
    s_cbranch_scc1 L_nohdr2
    v_add_u32 v115, 0x9e3779b9, v115
    v_mov_b32 v13, 16768
    ds_write_b32 v13, v115
L_nohdr2:
    s_nop 5
    v_permlane32_swap_b32 v28, v44
    v_permlane32_swap_b32 v29, v45
    v_permlane32_swap_b32 v30, v46
    v_permlane32_swap_b32 v31, v47
    v_permlane32_swap_b32 v32, v48
    v_permlane32_swap_b32 v33, v49
    v_permlane32_swap_b32 v34, v50
    v_permlane32_swap_b32 v35, v51
    v_permlane32_swap_b32 v36, v52
    v_permlane32_swap_b32 v37, v53
    v_permlane32_swap_b32 v38, v54
    v_permlane32_swap_b32 v39, v55
    v_permlane32_swap_b32 v40, v56
    v_permlane32_swap_b32 v41, v57
    v_permlane32_swap_b32 v42, v58
    v_permlane32_swap_b32 v43, v59
    v_add_f32_dpp v28, v44, v28 row_ror:4 row_mask:0xf bank_mask:0xf
    v_add_f32_dpp v29, v45, v29 row_ror:4 row_mask:0xf bank_mask:0xf
    v_add_f32_dpp v30, v46, v30 row_ror:4 row_mask:0xf bank_mask:0xf
    v_add_f32_dpp v31, v47, v31 row_ror:4 row_mask:0xf bank_mask:0xf
    v_add_f32_dpp v32, v48, v32 row_ror:4 row_mask:0xf bank_mask:0xf
    v_add_f32_dpp v33, v49, v33 row_ror:4 row_mask:0xf bank_mask:0xf
    v_add_f32_dpp v34, v50, v34 row_ror:4 row_mask:0xf bank_mask:0xf
    v_add_f32_dpp v35, v51, v35 row_ror:4 row_mask:0xf bank_mask:0xf
    v_add_f32_dpp v36, v52, v36 row_ror:4 row_mask:0xf bank_mask:0xf
    v_add_f32_dpp v37, v53, v37 row_ror:4 row_mask:0xf bank_mask:0xf
    v_add_f32_dpp v38, v54, v38 row_ror:4 row_mask:0xf bank_mask:0xf
    v_add_f32_dpp v39, v55, v39 row_ror:4 row_mask:0xf bank_mask:0xf
    v_add_f32_dpp v40, v56, v40 row_ror:4 row_mask:0xf bank_mask:0xf
    v_add_f32_dpp v41, v57, v41 row_ror:4 row_mask:0xf bank_mask:0xf
    v_add_f32_dpp v42, v58, v42 row_ror:4 row_mask:0xf bank_mask:0xf
    v_add_f32_dpp v43, v59, v43 row_ror:4 row_mask:0xf bank_mask:0xf
    v_mov_b32_dpp v28, v28 row_ror:4 row_mask:0xf bank_mask:0xa
    v_mov_b32_dpp v29, v29 row_ror:4 row_mask:0xf bank_mask:0xa
    v_mov_b32_dpp v30, v30 row_ror:4 row_mask:0xf bank_mask:0xa
    v_mov_b32_dpp v31, v31 row_ror:4 row_mask:0xf bank_mask:0xa
    v_mov_b32_dpp v32, v32 row_ror:4 row_mask:0xf bank_mask:0xa
    v_mov_b32_dpp v33, v33 row_ror:4 row_mask:0xf bank_mask:0xa
    v_mov_b32_dpp v34, v34 row_ror:4 row_mask:0xf bank_mask:0xa
    v_mov_b32_dpp v35, v35 row_ror:4 row_mask:0xf bank_mask:0xa
    v_mov_b32_dpp v36, v36 row_ror:4 row_mask:0xf bank_mask:0xa
    v_mov_b32_dpp v37, v37 row_ror:4 row_mask:0xf bank_mask:0xa
    v_mov_b32_dpp v38, v38 row_ror:4 row_mask:0xf bank_mask:0xa
    v_mov_b32_dpp v39, v39 row_ror:4 row_mask:0xf bank_mask:0xa
    v_mov_b32_dpp v40, v40 row_ror:4 row_mask:0xf bank_mask:0xa
    v_mov_b32_dpp v41, v41 row_ror:4 row_mask:0xf bank_mask:0xa
    v_mov_b32_dpp v42, v42 row_ror:4 row_mask:0xf bank_mask:0xa
    v_mov_b32_dpp v43, v43 row_ror:4 row_mask:0xf bank_mask:0xa
    v_max3_f32 v112, v28, v29, v30
    v_max3_f32 v112, v112, v31, v32
    v_max3_f32 v112, v112, v33, v34
    v_max3_f32 v112, v112, v35, v36
    v_max3_f32 v112, v112, v37, v38
    v_max3_f32 v112, v112, v39, v40
    v_max3_f32 v112, v112, v41, v42
    v_max_f32 v112, v112, v43
    v_mov_b32 v13, v112
    s_nop 1
    v_permlane32_swap_b32 v112, v13
    s_nop 0
    v_max_f32 v112, v112, v13
    v_mov_b32 v13, v112
    s_nop 1
    v_permlane16_swap_b32 v112, v13
    s_nop 0
    v_max_f32 v112, v112, v13
    v_mul_f32 v112, s67, v112
    v_xor_b32 v68, 0x80008000, v68
    v_xor_b32 v69, 0x80008000, v69
    v_xor_b32 v70, 0x80008000, v70
    v_xor_b32 v71, 0x80008000, v71
    v_xor_b32 v72, 0x80008000, v72
    v_xor_b32 v73, 0x80008000, v73
    v_xor_b32 v74, 0x80008000, v74
    v_xor_b32 v75, 0x80008000, v75
    ds_write_b32 v9, v112 offset:16384
    v_fma_f32 v28, v28, s67, -v112
    v_fma_f32 v29, v29, s67, -v112
    v_fma_f32 v30, v30, s67, -v112
    v_fma_f32 v31, v31, s67, -v112
    v_fma_f32 v32, v32, s67, -v112
    v_fma_f32 v33, v33, s67, -v112
    v_fma_f32 v34, v34, s67, -v112
    v_fma_f32 v35, v35, s67, -v112
    v_fma_f32 v36, v36, s67, -v112
    v_fma_f32 v37, v37, s67, -v112
    v_fma_f32 v38, v38, s67, -v112
    v_fma_f32 v39, v39, s67, -v112
    v_fma_f32 v40, v40, s67, -v112
    v_fma_f32 v41, v41, s67, -v112
    v_fma_f32 v42, v42, s67, -v112
    v_fma_f32 v43, v43, s67, -v112
    v_exp_f32 v28, v28
    v_exp_f32 v29, v29
    v_exp_f32 v30, v30
    v_exp_f32 v31, v31
    v_exp_f32 v32, v32
    v_exp_f32 v33, v33
    v_exp_f32 v34, v34
    v_exp_f32 v35, v35
    v_exp_f32 v36, v36
    v_exp_f32 v37, v37
    v_exp_f32 v38, v38
    v_exp_f32 v39, v39
    v_exp_f32 v40, v40
    v_exp_f32 v41, v41
    v_exp_f32 v42, v42
    v_exp_f32 v43, v43
    s_nop 0
    v_add_f32 v113, v28, v29
    v_add_f32 v113, v113, v30
    v_add_f32 v113, v113, v31
    v_add_f32 v113, v113, v32
    v_add_f32 v113, v113, v33
    v_add_f32 v113, v113, v34
    v_add_f32 v113, v113, v35
    v_add_f32 v113, v113, v36
    v_add_f32 v113, v113, v37
    v_add_f32 v113, v113, v38
    v_add_f32 v113, v113, v39
    v_add_f32 v113, v113, v40
    v_add_f32 v113, v113, v41
    v_add_f32 v113, v113, v42
    v_add_f32 v113, v113, v43
    v_lshlrev_b32 v100, 16, v60
    v_and_b32 v101, 0xffff0000, v60
    v_mul_f32 v100, v100, v28
    v_mul_f32 v101, v101, v29
    v_cvt_pk_bf16_f32 v76, v100, v101
    v_lshlrev_b32 v100, 16, v61
    v_and_b32 v101, 0xffff0000, v61
    v_mul_f32 v100, v100, v30
    v_mul_f32 v101, v101, v31
    v_cvt_pk_bf16_f32 v77, v100, v101
    v_lshlrev_b32 v100, 16, v62
    v_and_b32 v101, 0xffff0000, v62
    v_mul_f32 v100, v100, v32
    v_mul_f32 v101, v101, v33
    v_cvt_pk_bf16_f32 v78, v100, v101
    v_lshlrev_b32 v100, 16, v63
    v_and_b32 v101, 0xffff0000, v63
    v_mul_f32 v100, v100, v34
    v_mul_f32 v101, v101, v35
    v_cvt_pk_bf16_f32 v79, v100, v101
    v_lshlrev_b32 v100, 16, v64
    v_and_b32 v101, 0xffff0000, v64
    v_mul_f32 v100, v100, v36
    v_mul_f32 v101, v101, v37
    v_cvt_pk_bf16_f32 v80, v100, v101
    v_lshlrev_b32 v100, 16, v65
    v_and_b32 v101, 0xffff0000, v65
    v_mul_f32 v100, v100, v38
    v_mul_f32 v101, v101, v39
    v_cvt_pk_bf16_f32 v81, v100, v101
    v_lshlrev_b32 v100, 16, v66
    v_and_b32 v101, 0xffff0000, v66
    v_mul_f32 v100, v100, v40
    v_mul_f32 v101, v101, v41
    v_cvt_pk_bf16_f32 v82, v100, v101
    v_lshlrev_b32 v100, 16, v67
    v_and_b32 v101, 0xffff0000, v67
    v_mul_f32 v100, v100, v42
    v_mul_f32 v101, v101, v43
    v_cvt_pk_bf16_f32 v83, v100, v101
    v_mov_b32 v13, v113
    s_nop 1
    v_permlane32_swap_b32 v113, v13
    s_nop 0
    v_add_f32 v113, v113, v13
    v_mov_b32 v13, v113
    s_nop 1
    v_permlane16_swap_b32 v113, v13
    s_nop 0
    v_add_f32 v113, v113, v13
    ds_write_b32 v9, v113 offset:16512
    v_mfma_f32_16x16x16_bf16 v[108:111], v[68:69], v[76:77], 0
    v_mfma_f32_16x16x16_bf16 v[108:111], v[70:71], v[78:79], v[108:111]
    v_mfma_f32_16x16x16_bf16 v[108:111], v[72:73], v[80:81], v[108:111]
    v_mfma_f32_16x16x16_bf16 v[108:111], v[74:75], v[82:83], v[108:111]
    s_waitcnt lgkmcnt(0)
    s_barrier
    ds_read_b128 v[28:31], v8 offset:16384
    ds_read_b128 v[32:35], v8 offset:16400
    ds_read_b128 v[36:39], v8 offset:16512
    ds_read_b128 v[40:43], v8 offset:16528
    v_mov_b32 v13, 16768
    ds_read_b32 v115, v13
    v_bfe_u32 v13, v0, 2, 2
    v_lshlrev_b32 v14, 5, v13
    v_lshlrev_b32 v15, 2, v0
    v_lshlrev_b32 v12, 8, v13
    v_lshl_add_u32 v12, v6, 5, v12
    v_and_b32 v13, 3, v0
    v_lshl_add_u32 v12, v13, 3, v12
    v_lshl_add_u32 v12, v7, 1, v12
    s_waitcnt lgkmcnt(0)
    v_and_b32 v114, 0xff, v115
    v_max3_f32 v13, v28, v29, v30
    v_max3_f32 v13, v13, v31, v32
    v_max3_f32 v13, v13, v33, v34
    v_max_f32 v13, v13, v35
    v_and_b32 v13, s66, v13
    v_sub_f32 v11, v112, v13
    v_sub_f32 v28, v28, v13
    v_sub_f32 v29, v29, v13
    v_sub_f32 v30, v30, v13
    v_sub_f32 v31, v31, v13
    v_sub_f32 v32, v32, v13
    v_sub_f32 v33, v33, v13
    v_sub_f32 v34, v34, v13
    v_sub_f32 v35, v35, v13
    v_exp_f32 v11, v11
    v_exp_f32 v28, v28
    v_exp_f32 v29, v29
    v_exp_f32 v30, v30
    v_exp_f32 v31, v31
    v_exp_f32 v32, v32
    v_exp_f32 v33, v33
    v_exp_f32 v34, v34
    v_exp_f32 v35, v35
    v_mov_b32 v112, v13
    v_mul_f32 v113, v28, v36
    v_fmac_f32 v113, v29, v37
    v_fmac_f32 v113, v30, v38
    v_fmac_f32 v113, v31, v39
    v_fmac_f32 v113, v32, v40
    v_fmac_f32 v113, v33, v41
    v_fmac_f32 v113, v34, v42
    v_fmac_f32 v113, v35, v43
    s_cmp_eq_u32 s77, 7
    s_cbranch_scc1 L_midc
    v_or_b32 v126, v112, v114
    v_and_or_b32 v127, v113, s66, v114
    s_branch L_midd
L_midc:
    s_mov_b32 s83, 60000
    s_movk_i32 s8, 0x1000
    s_movk_i32 s9, 0x2000
    s_movk_i32 s10, 0x3000
L_midd:
    v_cndmask_b32 v84, 0, v76, s[68:69]
    v_cndmask_b32 v85, 0, v77, s[68:69]
    v_cndmask_b32 v86, 0, v76, s[70:71]
    v_cndmask_b32 v87, 0, v77, s[70:71]
    v_cndmask_b32 v88, 0, v76, s[72:73]
    v_cndmask_b32 v89, 0, v77, s[72:73]
    v_cndmask_b32 v90, 0, v76, s[74:75]
    v_cndmask_b32 v91, 0, v77, s[74:75]
    s_waitcnt vmcnt(4)
    v_cvt_f32_i32 v128, v128
    v_cvt_f32_i32 v132, v132
    v_cvt_f32_i32 v136, v136
    v_cvt_f32_i32 v140, v140
    v_cvt_pk_bf16_f32 v100, v128, v132
    v_cvt_pk_bf16_f32 v101, v136, v140
    v_cvt_f32_i32 v129, v129
    v_cvt_f32_i32 v133, v133
    v_cvt_f32_i32 v137, v137
    v_cvt_f32_i32 v141, v141
    v_mfma_f32_16x16x16_bf16 v[92:95], v[100:101], v[84:85], v[108:111]
    v_cvt_pk_bf16_f32 v102, v129, v133
    v_cvt_pk_bf16_f32 v103, v137, v141
    v_cvt_f32_i32 v130, v130
    v_cvt_f32_i32 v134, v134
    v_cvt_f32_i32 v138, v138
    v_cvt_f32_i32 v142, v142
    v_mfma_f32_16x16x16_bf16 v[92:95], v[102:103], v[86:87], v[92:95]
    v_cvt_pk_bf16_f32 v104, v130, v134
    v_cvt_pk_bf16_f32 v105, v138, v142
    v_cvt_f32_i32 v131, v131
    v_cvt_f32_i32 v135, v135
    v_cvt_f32_i32 v139, v139
    v_cvt_f32_i32 v143, v143
    v_mfma_f32_16x16x16_bf16 v[92:95], v[104:105], v[88:89], v[92:95]
    v_cvt_pk_bf16_f32 v106, v131, v135
    v_cvt_pk_bf16_f32 v107, v139, v143
    s_nop 1
    v_mfma_f32_16x16x16_bf16 v[92:95], v[106:107], v[90:91], v[92:95]
    s_waitcnt vmcnt(0)
    v_cvt_f32_i32 v144, v144
    v_cvt_f32_i32 v148, v148
    v_cvt_f32_i32 v152, v152
    v_cvt_f32_i32 v156, v156
    v_cvt_pk_bf16_f32 v100, v144, v148
    v_cvt_pk_bf16_f32 v101, v152, v156
    v_cvt_f32_i32 v145, v145
    v_cvt_f32_i32 v149, v149
    v_cvt_f32_i32 v153, v153
    v_cvt_f32_i32 v157, v157
    v_mfma_f32_16x16x16_bf16 v[96:99], v[100:101], v[84:85], v[108:111]
    v_cvt_pk_bf16_f32 v102, v145, v149
    v_cvt_pk_bf16_f32 v103, v153, v157
    v_cvt_f32_i32 v146, v146
    v_cvt_f32_i32 v150, v150
    v_cvt_f32_i32 v154, v154
    v_cvt_f32_i32 v158, v158
    v_mfma_f32_16x16x16_bf16 v[96:99], v[102:103], v[86:87], v[96:99]
    v_cvt_pk_bf16_f32 v104, v146, v150
    v_cvt_pk_bf16_f32 v105, v154, v158
    v_cvt_f32_i32 v147, v147
    v_cvt_f32_i32 v151, v151
    v_cvt_f32_i32 v155, v155
    v_cvt_f32_i32 v159, v159
    v_mfma_f32_16x16x16_bf16 v[96:99], v[104:105], v[88:89], v[96:99]
    v_cvt_pk_bf16_f32 v106, v147, v151
    v_cvt_pk_bf16_f32 v107, v155, v159
    s_nop 1
    v_mfma_f32_16x16x16_bf16 v[96:99], v[106:107], v[90:91], v[96:99]
    s_cmp_eq_u32 s77, 7
    s_cbranch_scc1 L_np0
    s_cmp_lg_u32 s80, 2
    s_cbranch_scc1 L_np0
    v_lshlrev_b32 v13, 3, v5
    s_mov_b64 exec, 15
    buffer_store_dwordx2 v[126:127], v13, s[4:7], s100 offen sc1
    s_mov_b64 exec, -1
L_np0:
    s_cmp_eq_u32 s77, 7
    s_cbranch_scc1 L_np1
    s_cmp_lg_u32 s80, 3
    s_cbranch_scc1 L_np1
    v_lshlrev_b32 v116, 7, v5
    s_mov_b64 exec, 0xffff
    buffer_load_dword v116, v116, s[52:55], s94 offen
    s_mov_b64 exec, -1
L_np1:
    buffer_load_dwordx4 v[128:131], v3, s[28:31], s97 offen offset:0 nt
    buffer_load_dwordx4 v[132:135], v3, s[28:31], s97 offen offset:512 nt
    buffer_load_dwordx4 v[136:139], v3, s[28:31], s97 offen offset:1024 nt
    buffer_load_dwordx4 v[140:143], v3, s[28:31], s97 offen offset:1536 nt
    buffer_load_dwordx4 v[144:147], v3, s[28:31], s97 offen offset:256 nt
    buffer_load_dwordx4 v[148:151], v3, s[28:31], s97 offen offset:768 nt
    buffer_load_dwordx4 v[152:155], v3, s[28:31], s97 offen offset:1280 nt
    buffer_load_dwordx4 v[156:159], v3, s[28:31], s97 offen offset:1792 nt
    v_cndmask_b32 v84, 0, v78, s[68:69]
    v_cndmask_b32 v85, 0, v79, s[68:69]
    v_cndmask_b32 v86, 0, v78, s[70:71]
    v_cndmask_b32 v87, 0, v79, s[70:71]
    v_cndmask_b32 v88, 0, v78, s[72:73]
    v_cndmask_b32 v89, 0, v79, s[72:73]
    v_cndmask_b32 v90, 0, v78, s[74:75]
    v_cndmask_b32 v91, 0, v79, s[74:75]
    s_waitcnt vmcnt(4)
    v_cvt_f32_i32 v128, v128
    v_cvt_f32_i32 v132, v132
    v_cvt_f32_i32 v136, v136
    v_cvt_f32_i32 v140, v140
    v_cvt_pk_bf16_f32 v100, v128, v132
    v_cvt_pk_bf16_f32 v101, v136, v140
    v_cvt_f32_i32 v129, v129
    v_cvt_f32_i32 v133, v133
    v_cvt_f32_i32 v137, v137
    v_cvt_f32_i32 v141, v141
    v_mfma_f32_16x16x16_bf16 v[92:95], v[100:101], v[84:85], v[92:95]
    v_cvt_pk_bf16_f32 v102, v129, v133
    v_cvt_pk_bf16_f32 v103, v137, v141
    v_cvt_f32_i32 v130, v130
    v_cvt_f32_i32 v134, v134
    v_cvt_f32_i32 v138, v138
    v_cvt_f32_i32 v142, v142
    v_mfma_f32_16x16x16_bf16 v[92:95], v[102:103], v[86:87], v[92:95]
    v_cvt_pk_bf16_f32 v104, v130, v134
    v_cvt_pk_bf16_f32 v105, v138, v142
    v_cvt_f32_i32 v131, v131
    v_cvt_f32_i32 v135, v135
    v_cvt_f32_i32 v139, v139
    v_cvt_f32_i32 v143, v143
    v_mfma_f32_16x16x16_bf16 v[92:95], v[104:105], v[88:89], v[92:95]
    v_cvt_pk_bf16_f32 v106, v131, v135
    v_cvt_pk_bf16_f32 v107, v139, v143
    s_nop 1
    v_mfma_f32_16x16x16_bf16 v[92:95], v[106:107], v[90:91], v[92:95]
    s_waitcnt vmcnt(0)
    v_cvt_f32_i32 v144, v144
    v_cvt_f32_i32 v148, v148
    v_cvt_f32_i32 v152, v152
    v_cvt_f32_i32 v156, v156
    v_cvt_pk_bf16_f32 v100, v144, v148
    v_cvt_pk_bf16_f32 v101, v152, v156
    v_cvt_f32_i32 v145, v145
    v_cvt_f32_i32 v149, v149
    v_cvt_f32_i32 v153, v153
    v_cvt_f32_i32 v157, v157
    v_mfma_f32_16x16x16_bf16 v[96:99], v[100:101], v[84:85], v[96:99]
    v_cvt_pk_bf16_f32 v102, v145, v149
    v_cvt_pk_bf16_f32 v103, v153, v157
    v_cvt_f32_i32 v146, v146
    v_cvt_f32_i32 v150, v150
    v_cvt_f32_i32 v154, v154
    v_cvt_f32_i32 v158, v158
    v_mfma_f32_16x16x16_bf16 v[96:99], v[102:103], v[86:87], v[96:99]
    v_cvt_pk_bf16_f32 v104, v146, v150
    v_cvt_pk_bf16_f32 v105, v154, v158
    v_cvt_f32_i32 v147, v147
    v_cvt_f32_i32 v151, v151
    v_cvt_f32_i32 v155, v155
    v_cvt_f32_i32 v159, v159
    v_mfma_f32_16x16x16_bf16 v[96:99], v[104:105], v[88:89], v[96:99]
    v_cvt_pk_bf16_f32 v106, v147, v151
    v_cvt_pk_bf16_f32 v107, v155, v159
    s_nop 1
    v_mfma_f32_16x16x16_bf16 v[96:99], v[106:107], v[90:91], v[96:99]
    buffer_load_dwordx4 v[128:131], v3, s[28:31], s98 offen offset:0 nt
    buffer_load_dwordx4 v[132:135], v3, s[28:31], s98 offen offset:512 nt
    buffer_load_dwordx4 v[136:139], v3, s[28:31], s98 offen offset:1024 nt
    buffer_load_dwordx4 v[140:143], v3, s[28:31], s98 offen offset:1536 nt
    buffer_load_dwordx4 v[144:147], v3, s[28:31], s98 offen offset:256 nt
    buffer_load_dwordx4 v[148:151], v3, s[28:31], s98 offen offset:768 nt
    buffer_load_dwordx4 v[152:155], v3, s[28:31], s98 offen offset:1280 nt
    buffer_load_dwordx4 v[156:159], v3, s[28:31], s98 offen offset:1792 nt
    v_cndmask_b32 v84, 0, v80, s[68:69]
    v_cndmask_b32 v85, 0, v81, s[68:69]
    v_cndmask_b32 v86, 0, v80, s[70:71]
    v_cndmask_b32 v87, 0, v81, s[70:71]
    v_cndmask_b32 v88, 0, v80, s[72:73]
    v_cndmask_b32 v89, 0, v81, s[72:73]
    v_cndmask_b32 v90, 0, v80, s[74:75]
    v_cndmask_b32 v91, 0, v81, s[74:75]
    s_waitcnt vmcnt(4)
    v_cvt_f32_i32 v128, v128
    v_cvt_f32_i32 v132, v132
    v_cvt_f32_i32 v136, v136
    v_cvt_f32_i32 v140, v140
    v_cvt_pk_bf16_f32 v100, v128, v132
    v_cvt_pk_bf16_f32 v101, v136, v140
    v_cvt_f32_i32 v129, v129
    v_cvt_f32_i32 v133, v133
    v_cvt_f32_i32 v137, v137
    v_cvt_f32_i32 v141, v141
    v_mfma_f32_16x16x16_bf16 v[92:95], v[100:101], v[84:85], v[92:95]
    v_cvt_pk_bf16_f32 v102, v129, v133
    v_cvt_pk_bf16_f32 v103, v137, v141
    v_cvt_f32_i32 v130, v130
    v_cvt_f32_i32 v134, v134
    v_cvt_f32_i32 v138, v138
    v_cvt_f32_i32 v142, v142
    v_mfma_f32_16x16x16_bf16 v[92:95], v[102:103], v[86:87], v[92:95]
    v_cvt_pk_bf16_f32 v104, v130, v134
    v_cvt_pk_bf16_f32 v105, v138, v142
    v_cvt_f32_i32 v131, v131
    v_cvt_f32_i32 v135, v135
    v_cvt_f32_i32 v139, v139
    v_cvt_f32_i32 v143, v143
    v_mfma_f32_16x16x16_bf16 v[92:95], v[104:105], v[88:89], v[92:95]
    v_cvt_pk_bf16_f32 v106, v131, v135
    v_cvt_pk_bf16_f32 v107, v139, v143
    s_nop 1
    v_mfma_f32_16x16x16_bf16 v[92:95], v[106:107], v[90:91], v[92:95]
    s_waitcnt vmcnt(0)
    v_cvt_f32_i32 v144, v144
    v_cvt_f32_i32 v148, v148
    v_cvt_f32_i32 v152, v152
    v_cvt_f32_i32 v156, v156
    v_cvt_pk_bf16_f32 v100, v144, v148
    v_cvt_pk_bf16_f32 v101, v152, v156
    v_cvt_f32_i32 v145, v145
    v_cvt_f32_i32 v149, v149
    v_cvt_f32_i32 v153, v153
    v_cvt_f32_i32 v157, v157
    v_mfma_f32_16x16x16_bf16 v[96:99], v[100:101], v[84:85], v[96:99]
    v_cvt_pk_bf16_f32 v102, v145, v149
    v_cvt_pk_bf16_f32 v103, v153, v157
    v_cvt_f32_i32 v146, v146
    v_cvt_f32_i32 v150, v150
    v_cvt_f32_i32 v154, v154
    v_cvt_f32_i32 v158, v158
    v_mfma_f32_16x16x16_bf16 v[96:99], v[102:103], v[86:87], v[96:99]
    v_cvt_pk_bf16_f32 v104, v146, v150
    v_cvt_pk_bf16_f32 v105, v154, v158
    v_cvt_f32_i32 v147, v147
    v_cvt_f32_i32 v151, v151
    v_cvt_f32_i32 v155, v155
    v_cvt_f32_i32 v159, v159
    v_mfma_f32_16x16x16_bf16 v[96:99], v[104:105], v[88:89], v[96:99]
    v_cvt_pk_bf16_f32 v106, v147, v151
    v_cvt_pk_bf16_f32 v107, v155, v159
    s_nop 1
    v_mfma_f32_16x16x16_bf16 v[96:99], v[106:107], v[90:91], v[96:99]
    v_lshrrev_b32 v126, 2, v8
    s_lshl_b32 s81, s77, 3
    s_add_u32 s65, s81, s80
    s_cmp_lg_u32 s65, 57
    s_cbranch_scc1 L_nost1
    buffer_load_dwordx2 v[28:29], v126, s[4:7], 0 offen offset:0 sc1
    buffer_load_dwordx2 v[30:31], v126, s[4:7], 0 offen offset:128 sc1
    buffer_load_dwordx2 v[32:33], v126, s[4:7], 0 offen offset:256 sc1
    buffer_load_dwordx2 v[34:35], v126, s[4:7], 0 offen offset:384 sc1
    buffer_load_dwordx2 v[36:37], v126, s[4:7], 0 offen offset:512 sc1
    buffer_load_dwordx2 v[38:39], v126, s[4:7], 0 offen offset:640 sc1
    buffer_load_dwordx2 v[40:41], v126, s[4:7], 0 offen offset:768 sc1
L_nost1:
    buffer_load_dwordx4 v[128:131], v3, s[28:31], s99 offen offset:0 nt
    buffer_load_dwordx4 v[132:135], v3, s[28:31], s99 offen offset:512 nt
    buffer_load_dwordx4 v[136:139], v3, s[28:31], s99 offen offset:1024 nt
    buffer_load_dwordx4 v[140:143], v3, s[28:31], s99 offen offset:1536 nt
    buffer_load_dwordx4 v[144:147], v3, s[28:31], s99 offen offset:256 nt
    buffer_load_dwordx4 v[148:151], v3, s[28:31], s99 offen offset:768 nt
    buffer_load_dwordx4 v[152:155], v3, s[28:31], s99 offen offset:1280 nt
    buffer_load_dwordx4 v[156:159], v3, s[28:31], s99 offen offset:1792 nt
    s_cmp_lg_u32 s65, 57
    s_cbranch_scc1 L_nost2
    s_waitcnt vmcnt(8)
L_stchk:
    v_xor_b32 v28, v28, v114
    v_xor_b32 v29, v29, v114
    v_xor_b32 v30, v30, v114
    v_xor_b32 v31, v31, v114
    v_xor_b32 v32, v32, v114
    v_xor_b32 v33, v33, v114
    v_xor_b32 v34, v34, v114
    v_xor_b32 v35, v35, v114
    v_xor_b32 v36, v36, v114
    v_xor_b32 v37, v37, v114
    v_xor_b32 v38, v38, v114
    v_xor_b32 v39, v39, v114
    v_xor_b32 v40, v40, v114
    v_xor_b32 v41, v41, v114
    v_or3_b32 v44, v28, v29, v30
    v_or3_b32 v45, v31, v32, v33
    v_or3_b32 v46, v34, v35, v36
    v_or3_b32 v47, v37, v38, v39
    v_or3_b32 v48, v44, v45, v46
    v_or3_b32 v49, v47, v40, v41
    v_or_b32 v13, v48, v49
    v_and_b32 v13, 0xff, v13
    v_cmp_ne_u32 vcc, 0, v13
    s_cbranch_vccz L_stok
    s_sub_u32 s83, s83, 1
    s_cbranch_scc1 L_stok
    buffer_load_dwordx2 v[28:29], v126, s[4:7], 0 offen offset:0 sc1
    buffer_load_dwordx2 v[30:31], v126, s[4:7], 0 offen offset:128 sc1
    buffer_load_dwordx2 v[32:33], v126, s[4:7], 0 offen offset:256 sc1
    buffer_load_dwordx2 v[34:35], v126, s[4:7], 0 offen offset:384 sc1
    buffer_load_dwordx2 v[36:37], v126, s[4:7], 0 offen offset:512 sc1
    buffer_load_dwordx2 v[38:39], v126, s[4:7], 0 offen offset:640 sc1
    buffer_load_dwordx2 v[40:41], v126, s[4:7], 0 offen offset:768 sc1
    s_waitcnt vmcnt(0)
    s_branch L_stchk
L_stok:
    v_max3_f32 v13, v112, v28, v30
    v_max3_f32 v13, v13, v32, v34
    v_max3_f32 v13, v13, v36, v38
    v_max_f32 v13, v13, v40
    v_sub_f32 v118, v28, v13
    v_sub_f32 v119, v30, v13
    v_sub_f32 v120, v32, v13
    v_sub_f32 v121, v34, v13
    v_sub_f32 v122, v36, v13
    v_sub_f32 v123, v38, v13
    v_sub_f32 v124, v40, v13
    v_sub_f32 v125, v112, v13
    v_exp_f32 v118, v118
    v_exp_f32 v119, v119
    v_exp_f32 v120, v120
    v_exp_f32 v121, v121
    v_exp_f32 v122, v122
    v_exp_f32 v123, v123
    v_exp_f32 v124, v124
    v_exp_f32 v125, v125
    s_nop 0
    v_mul_f32 v127, v125, v113
    v_fmac_f32 v127, v118, v29
    v_fmac_f32 v127, v119, v31
    v_fmac_f32 v127, v120, v33
    v_fmac_f32 v127, v121, v35
    v_fmac_f32 v127, v122, v37
    v_fmac_f32 v127, v123, v39
    v_fmac_f32 v127, v124, v41
    v_rcp_f32 v127, v127
    s_nop 0
    v_mul_f32 v118, v118, v127
    v_mul_f32 v119, v119, v127
    v_mul_f32 v120, v120, v127
    v_mul_f32 v121, v121, v127
    v_mul_f32 v122, v122, v127
    v_mul_f32 v123, v123, v127
    v_mul_f32 v124, v124, v127
    v_mul_f32 v125, v125, v127
    ds_write_b128 v8, v[118:121] offset:16640
    ds_write_b128 v8, v[122:125] offset:16656
L_nost2:
    v_cndmask_b32 v84, 0, v82, s[68:69]
    v_cndmask_b32 v85, 0, v83, s[68:69]
    v_cndmask_b32 v86, 0, v82, s[70:71]
    v_cndmask_b32 v87, 0, v83, s[70:71]
    v_cndmask_b32 v88, 0, v82, s[72:73]
    v_cndmask_b32 v89, 0, v83, s[72:73]
    v_cndmask_b32 v90, 0, v82, s[74:75]
    v_cndmask_b32 v91, 0, v83, s[74:75]
    s_waitcnt vmcnt(4)
    v_cvt_f32_i32 v128, v128
    v_cvt_f32_i32 v132, v132
    v_cvt_f32_i32 v136, v136
    v_cvt_f32_i32 v140, v140
    v_cvt_pk_bf16_f32 v100, v128, v132
    v_cvt_pk_bf16_f32 v101, v136, v140
    v_cvt_f32_i32 v129, v129
    v_cvt_f32_i32 v133, v133
    v_cvt_f32_i32 v137, v137
    v_cvt_f32_i32 v141, v141
    v_mfma_f32_16x16x16_bf16 v[92:95], v[100:101], v[84:85], v[92:95]
    v_cvt_pk_bf16_f32 v102, v129, v133
    v_cvt_pk_bf16_f32 v103, v137, v141
    v_cvt_f32_i32 v130, v130
    v_cvt_f32_i32 v134, v134
    v_cvt_f32_i32 v138, v138
    v_cvt_f32_i32 v142, v142
    v_mfma_f32_16x16x16_bf16 v[92:95], v[102:103], v[86:87], v[92:95]
    v_cvt_pk_bf16_f32 v104, v130, v134
    v_cvt_pk_bf16_f32 v105, v138, v142
    v_cvt_f32_i32 v131, v131
    v_cvt_f32_i32 v135, v135
    v_cvt_f32_i32 v139, v139
    v_cvt_f32_i32 v143, v143
    v_mfma_f32_16x16x16_bf16 v[92:95], v[104:105], v[88:89], v[92:95]
    v_cvt_pk_bf16_f32 v106, v131, v135
    v_cvt_pk_bf16_f32 v107, v139, v143
    s_nop 1
    v_mfma_f32_16x16x16_bf16 v[92:95], v[106:107], v[90:91], v[92:95]
    s_waitcnt vmcnt(0)
    v_cvt_f32_i32 v144, v144
    v_cvt_f32_i32 v148, v148
    v_cvt_f32_i32 v152, v152
    v_cvt_f32_i32 v156, v156
    v_cvt_pk_bf16_f32 v100, v144, v148
    v_cvt_pk_bf16_f32 v101, v152, v156
    v_cvt_f32_i32 v145, v145
    v_cvt_f32_i32 v149, v149
    v_cvt_f32_i32 v153, v153
    v_cvt_f32_i32 v157, v157
    v_mfma_f32_16x16x16_bf16 v[96:99], v[100:101], v[84:85], v[96:99]
    v_cvt_pk_bf16_f32 v102, v145, v149
    v_cvt_pk_bf16_f32 v103, v153, v157
    v_mul_f32 v92, v11, v92
    v_mul_f32 v93, v11, v93
    v_mul_f32 v94, v11, v94
    v_mul_f32 v95, v11, v95
    ds_write_b128 v10, v[92:95] offset:0
    v_cvt_f32_i32 v146, v146
    v_cvt_f32_i32 v150, v150
    v_cvt_f32_i32 v154, v154
    v_cvt_f32_i32 v158, v158
    v_mfma_f32_16x16x16_bf16 v[96:99], v[102:103], v[86:87], v[96:99]
    v_cvt_pk_bf16_f32 v104, v146, v150
    v_cvt_pk_bf16_f32 v105, v154, v158
    v_cvt_f32_i32 v147, v147
    v_cvt_f32_i32 v151, v151
    v_cvt_f32_i32 v155, v155
    v_cvt_f32_i32 v159, v159
    v_mfma_f32_16x16x16_bf16 v[96:99], v[104:105], v[88:89], v[96:99]
    v_cvt_pk_bf16_f32 v106, v147, v151
    v_cvt_pk_bf16_f32 v107, v155, v159
    s_nop 1
    v_mfma_f32_16x16x16_bf16 v[96:99], v[106:107], v[90:91], v[96:99]
    s_nop 7
    v_mul_f32 v96, v11, v96
    v_mul_f32 v97, v11, v97
    v_mul_f32 v98, v11, v98
    v_mul_f32 v99, v11, v99
    ds_write_b128 v10, v[96:99] offset:1024
    s_cmp_lg_u32 s77, 7
    s_cbranch_scc1 L_noearly
    buffer_load_dword v28, v15, s[52:55], 0 offen offset:0 sc1
    buffer_load_dword v29, v15, s[52:55], 0 offen offset:2048 sc1
    buffer_load_dword v30, v15, s[52:55], s8 offen offset:0 sc1
    buffer_load_dword v31, v15, s[52:55], s8 offen offset:2048 sc1
    buffer_load_dword v32, v15, s[52:55], s9 offen offset:0 sc1
    buffer_load_dword v33, v15, s[52:55], s9 offen offset:2048 sc1
    buffer_load_dword v34, v15, s[52:55], s10 offen offset:0 sc1
L_noearly:
    s_waitcnt lgkmcnt(0)
    s_barrier
    ds_read_b32 v44, v15 offset:0
    ds_read_b32 v45, v15 offset:2048
    ds_read_b32 v46, v15 offset:4096
    ds_read_b32 v47, v15 offset:6144
    ds_read_b32 v48, v15 offset:8192
    ds_read_b32 v49, v15 offset:10240
    ds_read_b32 v50, v15 offset:12288
    ds_read_b32 v51, v15 offset:14336
    ds_read_b128 v[118:121], v14 offset:16640
    ds_read_b128 v[122:125], v14 offset:16656
    s_waitcnt lgkmcnt(6)
    v_pk_add_f32 v[44:45], v[44:45], v[46:47]
    s_waitcnt lgkmcnt(2)
    v_pk_add_f32 v[48:49], v[48:49], v[50:51]
    v_pk_add_f32 v[44:45], v[44:45], v[48:49]
    s_cmp_eq_u32 s77, 7
    v_add_f32 v92, v44, v45
    s_cbranch_scc1 L_comb
    v_and_or_b32 v92, v92, s66, v114
    buffer_store_dword v92, v15, s[52:55], s94 offen sc1
    s_branch L_end
L_comb:
    s_waitcnt lgkmcnt(0)
    v_mul_f32 v92, v125, v92
L_poll:
    s_waitcnt vmcnt(0)
    v_xor_b32 v28, v28, v114
    v_xor_b32 v29, v29, v114
    v_xor_b32 v30, v30, v114
    v_xor_b32 v31, v31, v114
    v_xor_b32 v32, v32, v114
    v_xor_b32 v33, v33, v114
    v_xor_b32 v34, v34, v114
    v_or3_b32 v100, v28, v29, v30
    v_or3_b32 v101, v31, v32, v33
    v_or3_b32 v13, v100, v101, v34
    v_and_b32 v13, 0xff, v13
    v_cmp_ne_u32 vcc, 0, v13
    s_cbranch_vccz L_fin0
    buffer_load_dword v28, v15, s[52:55], 0 offen offset:0 sc1
    buffer_load_dword v29, v15, s[52:55], 0 offen offset:2048 sc1
    buffer_load_dword v30, v15, s[52:55], s8 offen offset:0 sc1
    buffer_load_dword v31, v15, s[52:55], s8 offen offset:2048 sc1
    buffer_load_dword v32, v15, s[52:55], s9 offen offset:0 sc1
    buffer_load_dword v33, v15, s[52:55], s9 offen offset:2048 sc1
    buffer_load_dword v34, v15, s[52:55], s10 offen offset:0 sc1
    s_sub_u32 s83, s83, 1
    s_cbranch_scc0 L_poll
L_fin0:
    v_fmac_f32 v92, v118, v28
    v_fmac_f32 v92, v119, v29
    v_fmac_f32 v92, v120, v30
    v_fmac_f32 v92, v121, v31
    v_fmac_f32 v92, v122, v32
    v_fmac_f32 v92, v123, v33
    v_fmac_f32 v92, v124, v34
L_out:
    v_cvt_pk_bf16_f32 v92, v92, v92
    buffer_store_short v92, v12, s[56:59], 0 offen sc1
    s_cmp_lg_u32 s80, 0
    s_cbranch_scc1 L_end
    v_mov_b32 v116, 0
    s_mov_b64 exec, 1
    buffer_store_dword v115, v116, s[60:63], 0 offen sc1
    s_mov_b64 exec, -1
L_end:
    s_endpgm
L_codeend:
.section .rodata,"a"
.p2align 6
.amdhsa_kernel standalone__kv_cache_quant_int4_int2_kv_with_per_channel_or_per_token_scales__decode_kernel
  .amdhsa_next_free_vgpr 256
  .amdhsa_next_free_sgpr 102
  .amdhsa_accum_offset 256
  .amdhsa_group_segment_fixed_size 0
  .amdhsa_kernarg_size 80
  .amdhsa_user_sgpr_count 2
  .amdhsa_user_sgpr_kernarg_segment_ptr 1
  .amdhsa_system_sgpr_workgroup_id_x 1
.end_amdhsa_kernel
```
